```python
import torch

def _softmax(x, axis=-1):
    return torch.softmax(x, dim=axis)
def _gelu(x):
    return torch.nn.functional.gelu(x, approximate="tanh")
def _silu(x):
    return torch.nn.functional.silu(x)
def _sigmoid(x):
    return torch.sigmoid(x)
def _layernorm(x, axis=-1, eps=1e-5):
    m = x.mean(dim=axis, keepdim=True)
    v = x.var(dim=axis, keepdim=True, unbiased=False)
    return (x - m) / torch.sqrt(v + eps)
def _scatter_add(tgt, idx, src, axis=0):
    return tgt.clone().index_add_(axis, idx, src)
def _segment_sum(src, seg, n):
    out = torch.zeros((n,) + src.shape[1:], dtype=src.dtype)
    return out.index_add_(0, seg, src)
def _pad(x, pw):
    flat = tuple(v for pair in reversed(pw) for v in pair)
    return torch.nn.functional.pad(x, flat)

kernel_name = 'standalone__glu_gated_bilinear__decode'

def setup_inputs():

    _w = (lambda a: (lambda t: t.to(torch.bfloat16) if t.is_floating_point() else t)(torch.as_tensor(a)))
    B, S, D, F = 1, 1, 1024, 3584
    return {
        "x": _w((lambda *s: torch.randn(*s, dtype=torch.bfloat16) * 0.05)(B, S, D)),
        "w_gate": _w((lambda *s: torch.randn(*s, dtype=torch.bfloat16) * 0.05)(D, F) * (D ** -0.5)),
        "w_up": _w((lambda *s: torch.randn(*s, dtype=torch.bfloat16) * 0.05)(D, F) * (D ** -0.5)),
        "w_down": _w((lambda *s: torch.randn(*s, dtype=torch.bfloat16) * 0.05)(F, D) * (F ** -0.5)),
    }

def reference(x, w_gate, w_up, w_down):
    g = torch.einsum("bsd,df->bsf", x, w_gate)
    u = torch.einsum("bsd,df->bsf", x, w_up)
    h = g * u
    return torch.einsum("bsf,fd->bsd", h, w_down)
```

```asm
; @launch grid=(256,1,1) block=(512,1,1) lds=0
.amdgcn_target "amdgcn-amd-amdhsa--gfx950"
.text
.globl standalone__glu_gated_bilinear__decode_kernel
.p2align 8
.type standalone__glu_gated_bilinear__decode_kernel,@function
standalone__glu_gated_bilinear__decode_kernel:
  s_load_dwordx2 s[8:9], s[0:1], 8
  s_load_dwordx2 s[12:13], s[0:1], 16
  s_load_dwordx2 s[4:5], s[0:1], 0
  s_load_dwordx2 s[28:29], s[0:1], 48
  s_load_dwordx2 s[24:25], s[0:1], 40
  v_readfirstlane_b32 s3, v0
  v_and_b32 v0, 63, v0
  s_lshr_b32 s33, s2, 5
  s_and_b32 s32, s2, 7
  s_sub_u32 s33, s33, 1
  s_mov_b32 s31, 0x20000
  s_mov_b32 s30, 946176
  s_lshr_b32 s3, s3, 6
  s_cmp_ge_u32 s33, 7
  s_cbranch_scc1 L_helper
  s_bfe_u32 s34, s2, 0x20003
  v_lshrrev_b32 v2, 3, v0
  v_and_b32 v3, 7, v0
  v_mov_b32 v12, 0
  v_mov_b32 v13, 0
  v_mov_b32 v14, 0
  v_mov_b32 v15, 0
  s_cmp_ge_u32 s3, 4
  s_cbranch_scc1 L_ph2
  s_mul_i32 s36, s32, 7
  s_lshl_b32 s37, s3, 2
  s_lshr_b32 s58, 0x4352, s37
  s_and_b32 s58, s58, 15
  s_add_u32 s58, s58, s33
  s_sub_u32 s57, s58, 7
  s_min_u32 s58, s58, s57
  s_add_u32 s58, s58, s36
  s_and_b32 s57, s3, 1
  s_lshl1_add_u32 s57, s34, s57
  s_mul_i32 s36, s57, 917504
  s_lshl_b32 s37, s58, 7
  s_add_u32 s41, s36, s37
  v_mul_u32_u24 v1, 114688, v2
  v_lshl_add_u32 v1, v3, 4, v1
  s_lshl_b32 s37, s57, 8
  v_lshlrev_b32 v4, 5, v2
  v_lshrrev_b32 v6, 4, v0
  v_lshl_add_u32 v6, v3, 2, v6
  s_lshl_b32 s36, s58, 13
  s_lshl_b32 s59, s57, 10
  s_add_u32 s36, s36, s59
  s_and_b32 s59, s3, 2
  s_lshl_b32 s59, s59, 8
  s_add_u32 s36, s36, s59
  s_add_u32 s36, s36, 458752
  v_lshlrev_b32 v5, 4, v6
  v_add_u32 v5, s36, v5
  s_movk_i32 s6, 2048
  s_mov_b32 s7, s31
  s_mov_b32 s10, 7340032
  s_mov_b32 s11, s31
  s_cmp_ge_u32 s3, 2
  s_waitcnt lgkmcnt(0)
  s_cselect_b32 s8, s12, s8
  s_cselect_b32 s9, s13, s9
  buffer_load_dwordx4 v[32:35], v1, s[8:11], s41 offen nt
  buffer_load_dwordx4 v[24:27], v4, s[4:7], s37 offen
  buffer_load_dwordx4 v[28:31], v4, s[4:7], s37 offen offset:16
  s_addk_i32 s41, 7168
  buffer_load_dwordx4 v[36:39], v1, s[8:11], s41 offen nt
  s_addk_i32 s41, 7168
  buffer_load_dwordx4 v[40:43], v1, s[8:11], s41 offen nt
  s_addk_i32 s41, 7168
  buffer_load_dwordx4 v[44:47], v1, s[8:11], s41 offen nt
  s_addk_i32 s41, 7168
  buffer_load_dwordx4 v[48:51], v1, s[8:11], s41 offen nt
  s_addk_i32 s41, 7168
  buffer_load_dwordx4 v[52:55], v1, s[8:11], s41 offen nt
  s_addk_i32 s41, 7168
  buffer_load_dwordx4 v[56:59], v1, s[8:11], s41 offen nt
  s_addk_i32 s41, 7168
  buffer_load_dwordx4 v[60:63], v1, s[8:11], s41 offen nt
  s_addk_i32 s41, 7168
  buffer_load_dwordx4 v[64:67], v1, s[8:11], s41 offen nt
  s_addk_i32 s41, 7168
  buffer_load_dwordx4 v[68:71], v1, s[8:11], s41 offen nt
  s_addk_i32 s41, 7168
  buffer_load_dwordx4 v[72:75], v1, s[8:11], s41 offen nt
  s_addk_i32 s41, 7168
  buffer_load_dwordx4 v[76:79], v1, s[8:11], s41 offen nt
  s_addk_i32 s41, 7168
  buffer_load_dwordx4 v[80:83], v1, s[8:11], s41 offen nt
  s_addk_i32 s41, 7168
  buffer_load_dwordx4 v[84:87], v1, s[8:11], s41 offen nt
  s_addk_i32 s41, 7168
  buffer_load_dwordx4 v[88:91], v1, s[8:11], s41 offen nt
  s_addk_i32 s41, 7168
  buffer_load_dwordx4 v[92:95], v1, s[8:11], s41 offen nt
  v_mov_b32 v16, 0
  v_mov_b32 v17, 0
  v_mov_b32 v18, 0
  v_mov_b32 v19, 0
  v_mov_b32 v20, 0
  v_mov_b32 v21, 0
  v_mov_b32 v22, 0
  v_mov_b32 v23, 0
  s_mov_b32 s38, 0x05040100
  s_mov_b32 s39, 0x07060302
  s_mov_b32 s35, 400000
  s_lshl_b32 s65, s32, 5
  s_movk_i32 s26, 256
  s_mov_b32 s27, s31
  s_getreg_b32 s40, hwreg(HW_REG_XCC_ID)
  s_and_b32 s40, s40, 15
  s_lshl_b32 s40, s40, 27
  s_waitcnt vmcnt(14)
  v_perm_b32 v6, v36, v32, s38
  v_perm_b32 v7, v36, v32, s39
  v_dot2c_f32_bf16 v16, v24, v6
  v_dot2c_f32_bf16 v17, v24, v7
  v_perm_b32 v6, v37, v33, s38
  v_perm_b32 v7, v37, v33, s39
  v_dot2c_f32_bf16 v18, v24, v6
  v_dot2c_f32_bf16 v19, v24, v7
  v_perm_b32 v6, v38, v34, s38
  v_perm_b32 v7, v38, v34, s39
  v_dot2c_f32_bf16 v20, v24, v6
  v_dot2c_f32_bf16 v21, v24, v7
  v_perm_b32 v6, v39, v35, s38
  v_perm_b32 v7, v39, v35, s39
  v_dot2c_f32_bf16 v22, v24, v6
  v_dot2c_f32_bf16 v23, v24, v7
  s_waitcnt vmcnt(12)
  v_perm_b32 v6, v44, v40, s38
  v_perm_b32 v7, v44, v40, s39
  v_dot2c_f32_bf16 v16, v25, v6
  v_dot2c_f32_bf16 v17, v25, v7
  v_perm_b32 v6, v45, v41, s38
  v_perm_b32 v7, v45, v41, s39
  v_dot2c_f32_bf16 v18, v25, v6
  v_dot2c_f32_bf16 v19, v25, v7
  v_perm_b32 v6, v46, v42, s38
  v_perm_b32 v7, v46, v42, s39
  v_dot2c_f32_bf16 v20, v25, v6
  v_dot2c_f32_bf16 v21, v25, v7
  v_perm_b32 v6, v47, v43, s38
  v_perm_b32 v7, v47, v43, s39
  v_dot2c_f32_bf16 v22, v25, v6
  v_dot2c_f32_bf16 v23, v25, v7
  s_waitcnt vmcnt(10)
  v_perm_b32 v6, v52, v48, s38
  v_perm_b32 v7, v52, v48, s39
  v_dot2c_f32_bf16 v16, v26, v6
  v_dot2c_f32_bf16 v17, v26, v7
  v_perm_b32 v6, v53, v49, s38
  v_perm_b32 v7, v53, v49, s39
  v_dot2c_f32_bf16 v18, v26, v6
  v_dot2c_f32_bf16 v19, v26, v7
  v_perm_b32 v6, v54, v50, s38
  v_perm_b32 v7, v54, v50, s39
  v_dot2c_f32_bf16 v20, v26, v6
  v_dot2c_f32_bf16 v21, v26, v7
  v_perm_b32 v6, v55, v51, s38
  v_perm_b32 v7, v55, v51, s39
  v_dot2c_f32_bf16 v22, v26, v6
  v_dot2c_f32_bf16 v23, v26, v7
  s_waitcnt vmcnt(8)
  v_perm_b32 v6, v60, v56, s38
  v_perm_b32 v7, v60, v56, s39
  v_dot2c_f32_bf16 v16, v27, v6
  v_dot2c_f32_bf16 v17, v27, v7
  v_perm_b32 v6, v61, v57, s38
  v_perm_b32 v7, v61, v57, s39
  v_dot2c_f32_bf16 v18, v27, v6
  v_dot2c_f32_bf16 v19, v27, v7
  v_perm_b32 v6, v62, v58, s38
  v_perm_b32 v7, v62, v58, s39
  v_dot2c_f32_bf16 v20, v27, v6
  v_dot2c_f32_bf16 v21, v27, v7
  v_perm_b32 v6, v63, v59, s38
  v_perm_b32 v7, v63, v59, s39
  v_dot2c_f32_bf16 v22, v27, v6
  v_dot2c_f32_bf16 v23, v27, v7
  s_waitcnt vmcnt(6)
  v_perm_b32 v6, v68, v64, s38
  v_perm_b32 v7, v68, v64, s39
  v_dot2c_f32_bf16 v16, v28, v6
  v_dot2c_f32_bf16 v17, v28, v7
  v_perm_b32 v6, v69, v65, s38
  v_perm_b32 v7, v69, v65, s39
  v_dot2c_f32_bf16 v18, v28, v6
  v_dot2c_f32_bf16 v19, v28, v7
  v_perm_b32 v6, v70, v66, s38
  v_perm_b32 v7, v70, v66, s39
  v_dot2c_f32_bf16 v20, v28, v6
  v_dot2c_f32_bf16 v21, v28, v7
  v_perm_b32 v6, v71, v67, s38
  v_perm_b32 v7, v71, v67, s39
  v_dot2c_f32_bf16 v22, v28, v6
  v_dot2c_f32_bf16 v23, v28, v7
  s_waitcnt vmcnt(4)
  v_perm_b32 v6, v76, v72, s38
  v_perm_b32 v7, v76, v72, s39
  v_dot2c_f32_bf16 v16, v29, v6
  v_dot2c_f32_bf16 v17, v29, v7
  v_perm_b32 v6, v77, v73, s38
  v_perm_b32 v7, v77, v73, s39
  v_dot2c_f32_bf16 v18, v29, v6
  v_dot2c_f32_bf16 v19, v29, v7
  v_perm_b32 v6, v78, v74, s38
  v_perm_b32 v7, v78, v74, s39
  v_dot2c_f32_bf16 v20, v29, v6
  v_dot2c_f32_bf16 v21, v29, v7
  v_perm_b32 v6, v79, v75, s38
  v_perm_b32 v7, v79, v75, s39
  v_dot2c_f32_bf16 v22, v29, v6
  v_dot2c_f32_bf16 v23, v29, v7
  s_waitcnt vmcnt(2)
  s_load_dwordx8 s[68:75], s[24:25], s65
  v_perm_b32 v6, v84, v80, s38
  v_perm_b32 v7, v84, v80, s39
  v_dot2c_f32_bf16 v16, v30, v6
  v_dot2c_f32_bf16 v17, v30, v7
  v_perm_b32 v6, v85, v81, s38
  v_perm_b32 v7, v85, v81, s39
  v_dot2c_f32_bf16 v18, v30, v6
  v_dot2c_f32_bf16 v19, v30, v7
  v_perm_b32 v6, v86, v82, s38
  v_perm_b32 v7, v86, v82, s39
  v_dot2c_f32_bf16 v20, v30, v6
  v_dot2c_f32_bf16 v21, v30, v7
  v_perm_b32 v6, v87, v83, s38
  v_perm_b32 v7, v87, v83, s39
  v_dot2c_f32_bf16 v22, v30, v6
  v_dot2c_f32_bf16 v23, v30, v7
  s_waitcnt lgkmcnt(0)
L_scka:
  s_and_b32 s36, s69, s71
  s_and_b32 s37, s73, s75
  s_and_b32 s36, s36, s37
  s_lshr_b32 s36, s36, 31
  s_and_b32 s36, s36, s68
  s_cbranch_scc0 L_sslowa
L_soka:
  v_mov_b32 v14, s68
  v_mov_b32 v15, s69
  s_xor_b32 s36, s69, s40
  s_xor_b32 s37, s71, s40
  s_or_b32 s47, s36, s37
  s_xor_b32 s36, s73, s40
  s_xor_b32 s37, s75, s40
  s_or_b32 s36, s36, s37
  s_or_b32 s47, s47, s36
  s_and_b32 s47, s47, 0x78000000
  s_waitcnt vmcnt(0)
  v_perm_b32 v6, v92, v88, s38
  v_perm_b32 v7, v92, v88, s39
  v_dot2c_f32_bf16 v16, v31, v6
  v_dot2c_f32_bf16 v17, v31, v7
  v_perm_b32 v6, v93, v89, s38
  v_perm_b32 v7, v93, v89, s39
  v_dot2c_f32_bf16 v18, v31, v6
  v_dot2c_f32_bf16 v19, v31, v7
  v_perm_b32 v6, v94, v90, s38
  v_perm_b32 v7, v94, v90, s39
  v_dot2c_f32_bf16 v20, v31, v6
  v_dot2c_f32_bf16 v21, v31, v7
  v_perm_b32 v6, v95, v91, s38
  v_perm_b32 v7, v95, v91, s39
  v_dot2c_f32_bf16 v22, v31, v6
  v_dot2c_f32_bf16 v23, v31, v7
  s_nop 1
  v_permlane32_swap_b32 v16, v20
  v_permlane32_swap_b32 v17, v21
  v_permlane32_swap_b32 v18, v22
  v_permlane32_swap_b32 v19, v23
  s_nop 0
  v_add_f32 v16, v16, v20
  v_add_f32 v17, v17, v21
  v_add_f32 v18, v18, v22
  v_add_f32 v19, v19, v23
  s_nop 0
  v_permlane16_swap_b32 v16, v18
  v_permlane16_swap_b32 v17, v19
  s_nop 0
  v_add_f32 v16, v16, v18
  v_add_f32 v17, v17, v19
  s_nop 0
  v_add_f32_dpp v12, v16, v16 row_ror:8 row_mask:0xf bank_mask:0xf
  v_add_f32_dpp v13, v17, v17 row_ror:8 row_mask:0xf bank_mask:0xf
  s_mov_b32 exec_lo, 0x00ff00ff
  s_mov_b32 exec_hi, 0x00ff00ff
  s_cmp_lg_u32 s47, 0
  s_cbranch_scc1 L_pfara
  buffer_store_dwordx4 v[12:15], v5, s[28:31], 0 offen
L_pdonea:
  s_barrier
  s_endpgm
L_ph2:
  s_load_dwordx2 s[16:17], s[0:1], 24
  s_mov_b32 s18, 7340032
  s_mov_b32 s19, s31
  s_mov_b32 s38, 0x05040100
  s_mov_b32 s39, 0x07060302
  s_mov_b32 s35, 400000
  s_lshl_b32 s65, s32, 5
  s_movk_i32 s26, 256
  s_mov_b32 s27, s31
  s_mul_i32 s36, s32, 7
  s_add_u32 s33, s33, s36
  s_and_b32 s64, s3, 3
  s_lshl2_add_u32 s37, s34, s64
  s_lshl_b32 s36, s33, 17
  s_lshl_b32 s59, s37, 7
  s_add_u32 s41, s36, s59
  v_lshlrev_b32 v1, 14, v2
  v_lshl_add_u32 v1, v3, 4, v1
  v_lshrrev_b32 v4, 1, v3
  v_mul_u32_u24 v4, 7168, v4
  v_and_b32 v5, 1, v3
  v_lshl_add_u32 v4, v5, 6, v4
  v_lshrrev_b32 v5, 4, v0
  v_lshl_add_u32 v4, v5, 4, v4
  s_mul_i32 s36, s37, 28672
  s_lshl_b32 s37, s33, 7
  s_add_u32 s36, s36, s37
  v_add_u32 v4, s36, v4
  s_lshl_b32 s37, s33, 8
  s_add_u32 s37, s37, 917504
  v_lshl_add_u32 v9, v2, 5, s37
  v_mov_b32 v11, 0
  s_getreg_b32 s40, hwreg(HW_REG_XCC_ID)
  s_and_b32 s40, s40, 15
  s_lshl_b32 s40, s40, 27
  s_mov_b64 exec, 0
  s_branch L_tail2
L_warm2:
  s_mov_b64 exec, -1
  s_waitcnt lgkmcnt(0)
  buffer_load_dwordx4 v[32:35], v1, s[16:19], s41 offen offset:0 nt
  buffer_load_dwordx4 v[36:39], v1, s[16:19], s41 offen offset:2048 nt
  s_addk_i32 s41, 4096
  buffer_load_dwordx4 v[40:43], v1, s[16:19], s41 offen offset:0 nt
  buffer_load_dwordx4 v[44:47], v1, s[16:19], s41 offen offset:2048 nt
  s_addk_i32 s41, 4096
  s_barrier
  buffer_load_dwordx4 v[48:51], v1, s[16:19], s41 offen offset:0 nt
  buffer_load_dwordx4 v[52:55], v1, s[16:19], s41 offen offset:2048 nt
  s_addk_i32 s41, 4096
  buffer_load_dwordx4 v[56:59], v1, s[16:19], s41 offen offset:0 nt
  buffer_load_dwordx4 v[60:63], v1, s[16:19], s41 offen offset:2048 nt
  s_load_dwordx8 s[68:75], s[24:25], s65
  v_mov_b32 v16, 0
  v_mov_b32 v17, 0
  v_mov_b32 v18, 0
  v_mov_b32 v19, 0
  v_mov_b32 v20, 0
  v_mov_b32 v21, 0
  v_mov_b32 v22, 0
  v_mov_b32 v23, 0
  s_waitcnt lgkmcnt(0)
L_sckb:
  s_and_b32 s36, s69, s71
  s_and_b32 s37, s73, s75
  s_and_b32 s36, s36, s37
  s_lshr_b32 s36, s36, 31
  s_and_b32 s36, s36, s68
  s_cbranch_scc0 L_sslowb
L_sokb:
  v_mov_b32 v14, s68
  v_mov_b32 v15, s69
  s_xor_b32 s36, s69, s40
  s_xor_b32 s37, s71, s40
  s_or_b32 s47, s36, s37
  s_xor_b32 s36, s73, s40
  s_xor_b32 s37, s75, s40
  s_or_b32 s36, s36, s37
  s_or_b32 s47, s47, s36
  s_and_b32 s47, s47, 0x78000000
  s_cselect_b32 s66, 14336, 0
  s_waitcnt vmcnt(6)
  v_perm_b32 v64, v36, v32, s38
  v_perm_b32 v65, v36, v32, s39
  v_perm_b32 v66, v37, v33, s38
  v_perm_b32 v67, v37, v33, s39
  v_perm_b32 v68, v38, v34, s38
  v_perm_b32 v69, v38, v34, s39
  v_perm_b32 v70, v39, v35, s38
  v_perm_b32 v71, v39, v35, s39
  s_waitcnt vmcnt(4)
  v_perm_b32 v72, v44, v40, s38
  v_perm_b32 v73, v44, v40, s39
  v_perm_b32 v74, v45, v41, s38
  v_perm_b32 v75, v45, v41, s39
  v_perm_b32 v76, v46, v42, s38
  v_perm_b32 v77, v46, v42, s39
  v_perm_b32 v78, v47, v43, s38
  v_perm_b32 v79, v47, v43, s39
  s_waitcnt vmcnt(2)
  buffer_load_dwordx4 v[24:27], v9, s[28:31], s66 offen sc1
  buffer_load_dwordx4 v[28:31], v9, s[28:31], s66 offen offset:16 sc1
  v_perm_b32 v80, v52, v48, s38
  v_perm_b32 v81, v52, v48, s39
  v_perm_b32 v82, v53, v49, s38
  v_perm_b32 v83, v53, v49, s39
  v_perm_b32 v84, v54, v50, s38
  v_perm_b32 v85, v54, v50, s39
  v_perm_b32 v86, v55, v51, s38
  v_perm_b32 v87, v55, v51, s39
  s_waitcnt vmcnt(2)
  v_perm_b32 v88, v60, v56, s38
  v_perm_b32 v89, v60, v56, s39
  v_perm_b32 v90, v61, v57, s38
  v_perm_b32 v91, v61, v57, s39
  v_perm_b32 v92, v62, v58, s38
  v_perm_b32 v93, v62, v58, s39
  v_perm_b32 v94, v63, v59, s38
  v_perm_b32 v95, v63, v59, s39
L_hchk2:
  s_waitcnt vmcnt(0)
  v_cmp_ne_u64 s[42:43], s[68:69], v[26:27]
  v_cmp_ne_u64 vcc, s[68:69], v[30:31]
  s_or_b64 s[42:43], s[42:43], vcc
  s_cbranch_scc1 L_hretry
L_tail2:
  v_dot2c_f32_bf16 v16, v24, v64
  v_dot2c_f32_bf16 v17, v24, v65
  v_dot2c_f32_bf16 v18, v24, v66
  v_dot2c_f32_bf16 v19, v24, v67
  v_dot2c_f32_bf16 v20, v24, v68
  v_dot2c_f32_bf16 v21, v24, v69
  v_dot2c_f32_bf16 v22, v24, v70
  v_dot2c_f32_bf16 v23, v24, v71
  v_dot2c_f32_bf16 v16, v25, v72
  v_dot2c_f32_bf16 v17, v25, v73
  v_dot2c_f32_bf16 v18, v25, v74
  v_dot2c_f32_bf16 v19, v25, v75
  v_dot2c_f32_bf16 v20, v25, v76
  v_dot2c_f32_bf16 v21, v25, v77
  v_dot2c_f32_bf16 v22, v25, v78
  v_dot2c_f32_bf16 v23, v25, v79
  v_dot2c_f32_bf16 v16, v28, v80
  v_dot2c_f32_bf16 v17, v28, v81
  v_dot2c_f32_bf16 v18, v28, v82
  v_dot2c_f32_bf16 v19, v28, v83
  v_dot2c_f32_bf16 v20, v28, v84
  v_dot2c_f32_bf16 v21, v28, v85
  v_dot2c_f32_bf16 v22, v28, v86
  v_dot2c_f32_bf16 v23, v28, v87
  v_dot2c_f32_bf16 v16, v29, v88
  v_dot2c_f32_bf16 v17, v29, v89
  v_dot2c_f32_bf16 v18, v29, v90
  v_dot2c_f32_bf16 v19, v29, v91
  v_dot2c_f32_bf16 v20, v29, v92
  v_dot2c_f32_bf16 v21, v29, v93
  v_dot2c_f32_bf16 v22, v29, v94
  v_dot2c_f32_bf16 v23, v29, v95
  s_nop 0
  v_permlane32_swap_b32 v16, v20
  v_permlane32_swap_b32 v17, v21
  v_permlane32_swap_b32 v18, v22
  v_permlane32_swap_b32 v19, v23
  s_nop 0
  v_add_f32 v16, v16, v20
  v_add_f32 v17, v17, v21
  v_add_f32 v18, v18, v22
  v_add_f32 v19, v19, v23
  s_nop 0
  v_permlane16_swap_b32 v16, v18
  v_permlane16_swap_b32 v17, v19
  s_nop 0
  v_add_f32 v16, v16, v18
  v_add_f32 v17, v17, v19
  s_nop 0
  v_add_f32_dpp v12, v16, v16 row_ror:8 row_mask:0xf bank_mask:0xf
  v_add_f32_dpp v13, v17, v17 row_ror:8 row_mask:0xf bank_mask:0xf
  s_cbranch_execz L_warm2
  s_mov_b32 exec_lo, 0x00ff00ff
  s_mov_b32 exec_hi, 0x00ff00ff
  buffer_store_dwordx4 v[12:15], v4, s[28:31], 0 offen sc1
  s_endpgm
L_hretry:
  buffer_load_dwordx4 v[24:27], v9, s[28:31], s66 offen sc1
  buffer_load_dwordx4 v[28:31], v9, s[28:31], s66 offen offset:16 sc1
  s_sub_u32 s35, s35, 1
  s_cmp_eq_u32 s35, 0
  s_cbranch_scc0 L_hchk2
  s_branch L_tail2
L_helper:
  s_cmp_ge_u32 s2, 32
  s_cbranch_scc1 L_end
  s_cmp_ge_u32 s3, 5
  s_cbranch_scc1 L_end
  s_movk_i32 s26, 256
  s_mov_b32 s27, s31
  s_lshl_b32 s65, s32, 5
  s_lshr_b32 s33, s2, 3
  v_mov_b32 v11, 0
  s_cmp_lg_u32 s3, 2
  s_cbranch_scc1 L_hcons
  s_memrealtime s[44:45]
  s_getreg_b32 s40, hwreg(HW_REG_XCC_ID)
  s_and_b32 s40, s40, 15
  s_lshl_b32 s40, s40, 27
  s_lshl3_add_u32 s37, s33, s65
  v_mov_b32 v16, 0
  v_mov_b32 v17, 0
  s_mov_b64 exec, 1
  s_waitcnt lgkmcnt(0)
  s_or_b32 s44, s44, 1
  s_and_b32 s45, s45, 0x07ffffff
  s_or_b32 s45, s45, s40
  s_bitset1_b32 s45, 31
  v_mov_b32 v14, s44
  v_mov_b32 v15, s45
  buffer_atomic_cmpswap_x2 v[14:17], v11, s[24:27], s37 offen sc1
  s_endpgm
L_hcons:
  s_load_dwordx2 s[20:21], s[0:1], 32
  s_movk_i32 s22, 2048
  s_mov_b32 s23, s31
  s_mov_b32 s35, 400000
  s_movk_i32 s41, 4096
  v_lshlrev_b32 v10, 4, v0
  s_cmp_lt_u32 s3, 2
  s_cbranch_scc1 L_hred
  s_lshl1_add_u32 s33, s33, s3
  s_sub_u32 s33, s33, 3
  s_cmp_ge_u32 s33, 7
  s_cbranch_scc1 L_end
  s_mul_i32 s36, s32, 7
  s_add_u32 s33, s33, s36
  s_lshl_b32 s36, s33, 13
  s_add_u32 s36, s36, 458752
  v_add_u32 v10, s36, v10
  s_lshl_b32 s36, s33, 8
  s_add_u32 s36, s36, 917504
  v_and_b32 v5, 31, v0
  v_lshrrev_b32 v5, 1, v5
  v_lshl_add_u32 v5, v5, 4, s36
  s_movk_i32 s64, 14336
  s_mov_b64 exec, 0
  s_branch L_got1
L_hhwarm:
  s_mov_b64 exec, -1
  s_waitcnt lgkmcnt(0)
  v_mov_b32 v12, 0
  v_mov_b32 v13, 0
  v_mov_b32 v14, 0
  v_mov_b32 v15, 0
  buffer_store_dwordx4 v[12:15], v5, s[28:31], 0 offen
L_hhn:
  s_sleep 20
  buffer_load_dwordx2 v[14:15], v11, s[24:27], s65 offen sc1
  s_sub_u32 s35, s35, 1
  s_cmp_eq_u32 s35, 0
  s_cbranch_scc1 L_end
  s_waitcnt vmcnt(0)
  v_min_u32 v6, v14, v15
  v_cmp_eq_u32 vcc, 0, v6
  s_cbranch_vccnz L_hhn
  buffer_load_dwordx4 v[32:35], v10, s[28:31], 0 offen offset:0 sc1
  buffer_load_dwordx4 v[36:39], v10, s[28:31], 0 offen offset:1024 sc1
  buffer_load_dwordx4 v[40:43], v10, s[28:31], 0 offen offset:2048 sc1
  buffer_load_dwordx4 v[44:47], v10, s[28:31], 0 offen offset:3072 sc1
  buffer_load_dwordx4 v[48:51], v10, s[28:31], s41 offen offset:0 sc1
  buffer_load_dwordx4 v[52:55], v10, s[28:31], s41 offen offset:1024 sc1
  buffer_load_dwordx4 v[56:59], v10, s[28:31], s41 offen offset:2048 sc1
  buffer_load_dwordx4 v[60:63], v10, s[28:31], s41 offen offset:3072 sc1
L_poll1chk:
  s_waitcnt vmcnt(0)
  v_cmp_ne_u64 s[48:49], v[34:35], v[14:15]
  v_cmp_ne_u64 s[50:51], v[38:39], v[14:15]
  v_cmp_ne_u64 s[52:53], v[42:43], v[14:15]
  v_cmp_ne_u64 s[54:55], v[46:47], v[14:15]
  v_cmp_ne_u64 s[56:57], v[50:51], v[14:15]
  v_cmp_ne_u64 s[58:59], v[54:55], v[14:15]
  v_cmp_ne_u64 s[60:61], v[58:59], v[14:15]
  v_cmp_ne_u64 s[62:63], v[62:63], v[14:15]
  v_add_f32 v16, v32, v36
  v_add_f32 v17, v33, v37
  v_add_f32 v18, v40, v44
  v_add_f32 v19, v41, v45
  v_add_f32 v20, v48, v52
  v_add_f32 v21, v49, v53
  v_add_f32 v22, v56, v60
  v_add_f32 v23, v57, v61
  s_or_b64 s[42:43], s[48:49], s[50:51]
  v_add_f32 v16, v16, v18
  s_or_b64 s[44:45], s[52:53], s[54:55]
  v_add_f32 v17, v17, v19
  s_or_b64 s[66:67], s[56:57], s[58:59]
  v_add_f32 v20, v20, v22
  s_or_b64 s[68:69], s[60:61], s[62:63]
  v_add_f32 v21, v21, v23
  s_or_b64 s[42:43], s[42:43], s[44:45]
  v_add_f32 v16, v16, v20
  s_or_b64 s[66:67], s[66:67], s[68:69]
  v_add_f32 v17, v17, v21
  v_cvt_pk_bf16_f32 v18, v16, v17
  v_mov_b32 v19, v18
  s_or_b64 s[42:43], s[42:43], s[66:67]
  s_cbranch_scc1 L_repoll
L_got1:
  v_permlane32_swap_b32 v18, v19
  s_nop 1
  v_lshlrev_b32 v16, 16, v18
  v_and_b32 v17, 0xffff0000, v18
  v_lshlrev_b32 v20, 16, v19
  v_and_b32 v21, 0xffff0000, v19
  v_mul_f32 v16, v16, v20
  v_mul_f32 v17, v17, v21
  v_cvt_pk_bf16_f32 v12, v16, v17
  s_nop 1
  v_mov_b32_dpp v13, v12 quad_perm:[1,0,3,2] row_mask:0xf bank_mask:0xf
  s_cbranch_execz L_hhwarm
  s_mov_b32 exec_lo, 0x55555555
  s_mov_b32 exec_hi, 0
  buffer_store_dwordx4 v[12:15], v5, s[28:31], 0 offen
  buffer_store_dwordx4 v[12:15], v5, s[28:31], s64 offen sc1
  s_endpgm
L_repoll:
  s_sub_u32 s35, s35, 1
  s_cmp_eq_u32 s35, 0
  s_cbranch_scc1 L_got1
  s_mov_b64 exec, s[48:49]
  s_cbranch_execz L_p1skip0
  buffer_load_dwordx4 v[32:35], v10, s[28:31], 0 offen offset:0 sc1
L_p1skip0:
  s_mov_b64 exec, s[50:51]
  s_cbranch_execz L_p1skip1
  buffer_load_dwordx4 v[36:39], v10, s[28:31], 0 offen offset:1024 sc1
L_p1skip1:
  s_mov_b64 exec, s[52:53]
  s_cbranch_execz L_p1skip2
  buffer_load_dwordx4 v[40:43], v10, s[28:31], 0 offen offset:2048 sc1
L_p1skip2:
  s_mov_b64 exec, s[54:55]
  s_cbranch_execz L_p1skip3
  buffer_load_dwordx4 v[44:47], v10, s[28:31], 0 offen offset:3072 sc1
L_p1skip3:
  s_mov_b64 exec, s[56:57]
  s_cbranch_execz L_p1skip4
  buffer_load_dwordx4 v[48:51], v10, s[28:31], s41 offen offset:0 sc1
L_p1skip4:
  s_mov_b64 exec, s[58:59]
  s_cbranch_execz L_p1skip5
  buffer_load_dwordx4 v[52:55], v10, s[28:31], s41 offen offset:1024 sc1
L_p1skip5:
  s_mov_b64 exec, s[60:61]
  s_cbranch_execz L_p1skip6
  buffer_load_dwordx4 v[56:59], v10, s[28:31], s41 offen offset:2048 sc1
L_p1skip6:
  s_mov_b64 exec, s[62:63]
  s_cbranch_execz L_p1skip7
  buffer_load_dwordx4 v[60:63], v10, s[28:31], s41 offen offset:3072 sc1
L_p1skip7:
  s_mov_b64 exec, -1
  s_branch L_poll1chk
L_hred:
  s_lshl1_add_u32 s33, s2, s3
  s_mul_i32 s36, s33, 7168
  v_add_u32 v10, s36, v10
  v_and_b32 v3, 7, v0
  v_lshlrev_b32 v3, 2, v3
  v_lshrrev_b32 v4, 5, v0
  v_lshl_add_u32 v3, v4, 1, v3
  s_lshl_b32 s36, s33, 5
  v_add_u32 v3, s36, v3
  v_lshrrev_b32 v4, 3, v0
  v_add_u32 v5, 0, v4
  v_mul_u32_u24 v5, 37, v5
  v_lshrrev_b32 v5, 8, v5
  v_lshlrev_b32 v80, 5, v5
  v_add_u32 v5, 8, v4
  v_mul_u32_u24 v5, 37, v5
  v_lshrrev_b32 v5, 8, v5
  v_lshlrev_b32 v81, 5, v5
  v_add_u32 v5, 16, v4
  v_mul_u32_u24 v5, 37, v5
  v_lshrrev_b32 v5, 8, v5
  v_lshlrev_b32 v82, 5, v5
  v_add_u32 v5, 24, v4
  v_mul_u32_u24 v5, 37, v5
  v_lshrrev_b32 v5, 8, v5
  v_lshlrev_b32 v83, 5, v5
  v_add_u32 v5, 32, v4
  v_mul_u32_u24 v5, 37, v5
  v_lshrrev_b32 v5, 8, v5
  v_lshlrev_b32 v84, 5, v5
  v_add_u32 v5, 40, v4
  v_mul_u32_u24 v5, 37, v5
  v_lshrrev_b32 v5, 8, v5
  v_lshlrev_b32 v85, 5, v5
  v_add_u32 v5, 48, v4
  v_mul_u32_u24 v5, 37, v5
  v_lshrrev_b32 v5, 8, v5
  v_lshlrev_b32 v86, 5, v5
  s_mov_b32 s34, 0
  s_mov_b64 s[48:49], 0
  s_mov_b64 s[50:51], 0
  s_mov_b64 s[52:53], 0
  s_mov_b64 s[54:55], 0
  s_mov_b64 s[56:57], 0
  s_mov_b64 s[58:59], 0
  s_mov_b64 s[60:61], 0
  s_mov_b64 exec, 0
  s_branch L_hchk
L_hwarm:
  s_mov_b64 exec, -1
  s_mov_b32 s34, 1
  s_waitcnt lgkmcnt(0)
L_hnonce:
  s_sleep 20
  buffer_load_dwordx2 v[64:65], v80, s[24:27], 0 offen sc1
  buffer_load_dwordx2 v[66:67], v81, s[24:27], 0 offen sc1
  buffer_load_dwordx2 v[68:69], v82, s[24:27], 0 offen sc1
  buffer_load_dwordx2 v[70:71], v83, s[24:27], 0 offen sc1
  buffer_load_dwordx2 v[72:73], v84, s[24:27], 0 offen sc1
  buffer_load_dwordx2 v[74:75], v85, s[24:27], 0 offen sc1
  buffer_load_dwordx2 v[76:77], v86, s[24:27], 0 offen sc1
  s_sub_u32 s35, s35, 1
  s_cmp_eq_u32 s35, 0
  s_cbranch_scc1 L_end
  s_waitcnt vmcnt(0)
  v_min3_u32 v6, v64, v65, v66
  v_min3_u32 v6, v6, v67, v68
  v_min3_u32 v6, v6, v69, v70
  v_min3_u32 v6, v6, v71, v72
  v_min3_u32 v6, v6, v73, v74
  v_min3_u32 v6, v6, v75, v76
  v_min_u32 v6, v6, v77
  v_cmp_eq_u32 vcc, 0, v6
  s_cbranch_vccnz L_hnonce
  s_mov_b32 exec_lo, 0x01010101
  s_mov_b32 exec_hi, 0x01010101
L_hwait:
  buffer_load_dwordx4 v[32:35], v10, s[28:31], 0 offen sc1
  s_sub_u32 s35, s35, 1
  s_cmp_eq_u32 s35, 0
  s_cbranch_scc1 L_end
  s_waitcnt vmcnt(0)
  v_cmp_eq_u64 vcc, v[34:35], v[64:65]
  s_cbranch_vccnz L_hgo
  s_sleep 2
  s_branch L_hwait
L_hgo:
  s_mov_b64 exec, -1
  buffer_load_dwordx4 v[32:35], v10, s[28:31], 0 offen offset:0 sc1
  buffer_load_dwordx4 v[36:39], v10, s[28:31], 0 offen offset:1024 sc1
  buffer_load_dwordx4 v[40:43], v10, s[28:31], 0 offen offset:2048 sc1
  buffer_load_dwordx4 v[44:47], v10, s[28:31], 0 offen offset:3072 sc1
  buffer_load_dwordx4 v[48:51], v10, s[28:31], s41 offen offset:0 sc1
  buffer_load_dwordx4 v[52:55], v10, s[28:31], s41 offen offset:1024 sc1
  buffer_load_dwordx4 v[56:59], v10, s[28:31], s41 offen offset:2048 sc1
L_hchk:
  s_waitcnt vmcnt(0)
  v_cmp_ne_u64 s[48:49], v[34:35], v[64:65]
  v_cmp_ne_u64 s[50:51], v[38:39], v[66:67]
  v_cmp_ne_u64 s[52:53], v[42:43], v[68:69]
  v_cmp_ne_u64 s[54:55], v[46:47], v[70:71]
  v_cmp_ne_u64 s[56:57], v[50:51], v[72:73]
  v_cmp_ne_u64 s[58:59], v[54:55], v[74:75]
  v_cmp_ne_u64 s[60:61], v[58:59], v[76:77]
  v_add_f32 v16, v32, v36
  v_add_f32 v17, v33, v37
  v_add_f32 v18, v40, v44
  v_add_f32 v19, v41, v45
  v_add_f32 v20, v48, v52
  v_add_f32 v21, v49, v53
  s_or_b64 s[42:43], s[48:49], s[50:51]
  v_add_f32 v16, v16, v56
  s_or_b64 s[44:45], s[52:53], s[54:55]
  v_add_f32 v17, v17, v57
  s_or_b64 s[46:47], s[56:57], s[58:59]
  v_add_f32 v18, v18, v20
  s_or_b64 s[42:43], s[42:43], s[60:61]
  v_add_f32 v19, v19, v21
  s_or_b64 s[44:45], s[44:45], s[46:47]
  v_add_f32 v16, v16, v18
  v_add_f32 v17, v17, v19
  s_or_b64 s[42:43], s[42:43], s[44:45]
  s_cbranch_scc1 L_hrepoll
L_hgot:
  v_permlane32_swap_b32 v16, v17
  s_nop 1
  v_add_f32 v16, v16, v17
  s_nop 1
  v_add_f32_dpp v16, v16, v16 row_ror:8 row_mask:0xf bank_mask:0xf
  s_nop 1
  v_mov_b32 v17, v16
  s_nop 1
  v_permlane16_swap_b32 v16, v17
  s_nop 1
  v_add_f32 v16, v16, v17
  v_cvt_pk_bf16_f32 v16, v16, v16
  s_cbranch_execz L_hre2
  s_mov_b32 exec_lo, 0xff
  s_mov_b32 exec_hi, 0xff
  buffer_store_short v16, v3, s[20:23], 0 offen
L_end:
  s_endpgm
L_hrepoll:
  s_sub_u32 s35, s35, 1
  s_cmp_eq_u32 s35, 0
  s_cbranch_scc1 L_hgot
L_hre2:
  s_mov_b64 exec, s[48:49]
  s_cbranch_execz L_hskip0
  buffer_load_dwordx4 v[32:35], v10, s[28:31], 0 offen offset:0 sc1
L_hskip0:
  s_mov_b64 exec, s[50:51]
  s_cbranch_execz L_hskip1
  buffer_load_dwordx4 v[36:39], v10, s[28:31], 0 offen offset:1024 sc1
L_hskip1:
  s_mov_b64 exec, s[52:53]
  s_cbranch_execz L_hskip2
  buffer_load_dwordx4 v[40:43], v10, s[28:31], 0 offen offset:2048 sc1
L_hskip2:
  s_mov_b64 exec, s[54:55]
  s_cbranch_execz L_hskip3
  buffer_load_dwordx4 v[44:47], v10, s[28:31], 0 offen offset:3072 sc1
L_hskip3:
  s_mov_b64 exec, s[56:57]
  s_cbranch_execz L_hskip4
  buffer_load_dwordx4 v[48:51], v10, s[28:31], s41 offen offset:0 sc1
L_hskip4:
  s_mov_b64 exec, s[58:59]
  s_cbranch_execz L_hskip5
  buffer_load_dwordx4 v[52:55], v10, s[28:31], s41 offen offset:1024 sc1
L_hskip5:
  s_mov_b64 exec, s[60:61]
  s_cbranch_execz L_hskip6
  buffer_load_dwordx4 v[56:59], v10, s[28:31], s41 offen offset:2048 sc1
L_hskip6:
  s_cmp_eq_u32 s34, 0
  s_cbranch_scc1 L_hwarm
  s_mov_b64 exec, -1
  s_branch L_hchk
L_pfara:
  buffer_store_dwordx4 v[12:15], v5, s[28:31], 0 offen sc1
  s_branch L_pdonea
L_sslowa:
  v_lshlrev_b32 v14, 2, v0
  buffer_load_dword v15, v14, s[24:27], s65 offen sc1
  s_sub_u32 s35, s35, 1
  s_waitcnt vmcnt(0)
  v_readlane_b32 s68, v15, 0
  v_readlane_b32 s69, v15, 1
  v_readlane_b32 s70, v15, 2
  v_readlane_b32 s71, v15, 3
  v_readlane_b32 s72, v15, 4
  v_readlane_b32 s73, v15, 5
  v_readlane_b32 s74, v15, 6
  v_readlane_b32 s75, v15, 7
  s_cmp_eq_u32 s35, 0
  s_cbranch_scc1 L_soka
  s_branch L_scka
L_sslowb:
  v_lshlrev_b32 v14, 2, v0
  buffer_load_dword v15, v14, s[24:27], s65 offen sc1
  s_sub_u32 s35, s35, 1
  s_waitcnt vmcnt(0)
  v_readlane_b32 s68, v15, 0
  v_readlane_b32 s69, v15, 1
  v_readlane_b32 s70, v15, 2
  v_readlane_b32 s71, v15, 3
  v_readlane_b32 s72, v15, 4
  v_readlane_b32 s73, v15, 5
  v_readlane_b32 s74, v15, 6
  v_readlane_b32 s75, v15, 7
  s_cmp_eq_u32 s35, 0
  s_cbranch_scc1 L_sokb
  s_branch L_sckb
.section .rodata,"a"
.p2align 6
.amdhsa_kernel standalone__glu_gated_bilinear__decode_kernel
  .amdhsa_next_free_vgpr 96
  .amdhsa_next_free_sgpr 80
  .amdhsa_accum_offset 96
  .amdhsa_group_segment_fixed_size 0
  .amdhsa_kernarg_size 56
  .amdhsa_user_sgpr_count 2
  .amdhsa_user_sgpr_kernarg_segment_ptr 1
  .amdhsa_system_sgpr_workgroup_id_x 1
  .amdhsa_float_denorm_mode_32 3
.end_amdhsa_kernel
```
